```python
import torch

def _softmax(x, axis=-1):
    return torch.softmax(x, dim=axis)
def _gelu(x):
    return torch.nn.functional.gelu(x, approximate="tanh")
def _silu(x):
    return torch.nn.functional.silu(x)
def _sigmoid(x):
    return torch.sigmoid(x)
def _layernorm(x, axis=-1, eps=1e-5):
    m = x.mean(dim=axis, keepdim=True)
    v = x.var(dim=axis, keepdim=True, unbiased=False)
    return (x - m) / torch.sqrt(v + eps)
def _scatter_add(tgt, idx, src, axis=0):
    return tgt.clone().index_add_(axis, idx, src)
def _segment_sum(src, seg, n):
    out = torch.zeros((n,) + src.shape[1:], dtype=src.dtype)
    return out.index_add_(0, seg, src)
def _pad(x, pw):
    flat = tuple(v for pair in reversed(pw) for v in pair)
    return torch.nn.functional.pad(x, flat)

kernel_name = 'standalone__mha_softmax__decode'

def setup_inputs():

    _w = (lambda a: (lambda t: t.to(torch.bfloat16) if t.is_floating_point() else t)(torch.as_tensor(a)))
    B, H, Sq, Sk, D = 1, 32, 1, 32768, 192
    return {
        "q": _w((lambda *s: torch.randn(*s, dtype=torch.bfloat16) * 0.8)(B, H, Sq, D)),
        "k": _w((lambda *s: torch.randn(*s, dtype=torch.bfloat16) * 0.8)(B, H, Sk, D)),
        "v": _w((lambda *s: torch.randn(*s, dtype=torch.bfloat16) * 0.05)(B, H, Sk, D)),
    }

def reference(q, k, v):
    scale = q.shape[-1] ** -0.5
    scores = torch.einsum("bhqd,bhkd->bhqk", q, k) * scale
    p = _softmax(scores, axis=-1)
    return torch.einsum("bhqk,bhkd->bhqd", p, v)
```

```asm
; @launch grid=(256,1,1) block=(64,1,1) lds=90000
.amdgcn_target "amdgcn-amd-amdhsa--gfx950"
.text
.globl standalone__mha_softmax__decode_kernel
.p2align 8
.type standalone__mha_softmax__decode_kernel,@function
standalone__mha_softmax__decode_kernel:
    s_cmp_ge_u32 s2, 256
    s_cbranch_scc1 L_end
    s_load_dwordx8 s[4:11], s[0:1], 0
    s_load_dwordx4 s[12:15], s[0:1], 32
    v_lshrrev_b32 v153, 3, v0
    v_and_b32 v5, 7, v0
    v_mul_u32_u24 v9, 384, v153
    v_lshlrev_b32 v3, 4, v5
    v_add_u32 v2, v3, v9
    v_lshrrev_b32 v8, 6, v0
    v_mul_u32_u24 v8, 30720, v8
    v_add_u32 v1, v2, v8
    s_lshr_b32 s40, s2, 3
    s_and_b32 s41, s2, 7
    s_mul_i32 s47, s40, 13
    s_mul_i32 s48, s41, 37
    s_add_u32 s47, s47, s48
    s_mul_hi_u32 s48, s47, 17747799
    s_mul_i32 s48, s48, 242
    s_sub_u32 s47, s47, s48
    s_mul_i32 s59, s40, 12582912
    s_mul_i32 s55, s41, 1486848
    s_add_u32 s55, s55, s59
    s_add_u32 s56, s55, 1486848
    s_mov_b32 s68, 33792
    s_mul_hi_u32 s48, s47, 390451573
    s_mul_i32 s48, s48, 11
    s_sub_u32 s47, s47, s48
    s_sub_u32 s88, 11, s47
    s_mul_i32 s48, s48, 6144
    s_mul_i32 s47, s47, 3072
    s_add_u32 s43, s55, s48
    s_add_u32 s43, s43, s47
    s_mov_b32 s89, 3072
    s_mov_b32 s90, 36864
    s_mul_i32 s36, s40, 384
    s_mov_b32 s18, 402653184
    s_mov_b32 s19, 0x20000
    s_mov_b32 s62, 12288
    s_mov_b32 s63, 0x20000
    s_lshl_b32 s64, s40, 3
    s_mov_b32 s67, 1
    s_mov_b32 s37, s43
    s_mov_b32 s71, s88
    s_waitcnt lgkmcnt(0)
    s_cmp_lg_u32 s41, 0
    s_cbranch_scc1 L_novol
    s_atomic_add s67, s[12:13], s64 glc
L_novol:
    s_mov_b64 s[16:17], s[6:7]
    s_mov_b64 s[60:61], s[4:5]
    buffer_load_dwordx4 v[20:23], v3, s[60:63], s36 offen offset:0
    buffer_load_dwordx4 v[24:27], v3, s[60:63], s36 offen offset:128
    buffer_load_dwordx4 v[28:31], v3, s[60:63], s36 offen offset:256
    s_mov_b32 s91, s43
    s_add_u32 s92, s43, s68
    s_sub_u32 s88, s88, 1
    s_cmp_eq_u32 s88, 0
    s_cselect_b32 s46, s90, s89
    s_cselect_b32 s88, 11, s88
    s_add_u32 s43, s43, s46
    s_cmp_eq_u32 s43, s56
    s_cselect_b32 s43, s55, s43
    buffer_load_dwordx4 v[52:55], v1, s[16:19], s91 offen offset:0 nt
    buffer_load_dwordx4 v[56:59], v1, s[16:19], s91 offen offset:128 nt
    buffer_load_dwordx4 v[60:63], v1, s[16:19], s91 offen offset:256 nt
    buffer_load_dwordx4 v[64:67], v1, s[16:19], s92 offen offset:0 nt
    buffer_load_dwordx4 v[68:71], v1, s[16:19], s92 offen offset:128 nt
    buffer_load_dwordx4 v[72:75], v1, s[16:19], s92 offen offset:256 nt
    s_mov_b32 s91, s43
    s_add_u32 s92, s43, s68
    s_sub_u32 s88, s88, 1
    s_cmp_eq_u32 s88, 0
    s_cselect_b32 s46, s90, s89
    s_cselect_b32 s88, 11, s88
    s_add_u32 s43, s43, s46
    s_cmp_eq_u32 s43, s56
    s_cselect_b32 s43, s55, s43
    buffer_load_dwordx4 v[76:79], v1, s[16:19], s91 offen offset:0 nt
    buffer_load_dwordx4 v[80:83], v1, s[16:19], s91 offen offset:128 nt
    buffer_load_dwordx4 v[84:87], v1, s[16:19], s91 offen offset:256 nt
    buffer_load_dwordx4 v[88:91], v1, s[16:19], s92 offen offset:0 nt
    buffer_load_dwordx4 v[92:95], v1, s[16:19], s92 offen offset:128 nt
    buffer_load_dwordx4 v[96:99], v1, s[16:19], s92 offen offset:256 nt
    s_mov_b32 s91, s43
    s_add_u32 s92, s43, s68
    s_sub_u32 s88, s88, 1
    s_cmp_eq_u32 s88, 0
    s_cselect_b32 s46, s90, s89
    s_cselect_b32 s88, 11, s88
    s_add_u32 s43, s43, s46
    s_cmp_eq_u32 s43, s56
    s_cselect_b32 s43, s55, s43
    buffer_load_dwordx4 v[100:103], v1, s[16:19], s91 offen offset:0 nt
    buffer_load_dwordx4 v[104:107], v1, s[16:19], s91 offen offset:128 nt
    buffer_load_dwordx4 v[108:111], v1, s[16:19], s91 offen offset:256 nt
    buffer_load_dwordx4 v[112:115], v1, s[16:19], s92 offen offset:0 nt
    buffer_load_dwordx4 v[116:119], v1, s[16:19], s92 offen offset:128 nt
    buffer_load_dwordx4 v[120:123], v1, s[16:19], s92 offen offset:256 nt
    s_mov_b32 s91, s43
    s_add_u32 s92, s43, s68
    s_sub_u32 s88, s88, 1
    s_cmp_eq_u32 s88, 0
    s_cselect_b32 s46, s90, s89
    s_cselect_b32 s88, 11, s88
    s_add_u32 s43, s43, s46
    s_cmp_eq_u32 s43, s56
    s_cselect_b32 s43, s55, s43
    buffer_load_dwordx4 v[124:127], v1, s[16:19], s91 offen offset:0 nt
    buffer_load_dwordx4 v[128:131], v1, s[16:19], s91 offen offset:128 nt
    buffer_load_dwordx4 v[132:135], v1, s[16:19], s91 offen offset:256 nt
    buffer_load_dwordx4 v[136:139], v1, s[16:19], s92 offen offset:0 nt
    buffer_load_dwordx4 v[140:143], v1, s[16:19], s92 offen offset:128 nt
    buffer_load_dwordx4 v[144:147], v1, s[16:19], s92 offen offset:256 nt
    s_mov_b32 s45, 0x3dd53b95
    s_mov_b64 s[96:97], s[10:11]
    s_mov_b32 s98, 12288
    s_mov_b32 s99, 0x20000
    s_mov_b64 s[32:33], s[14:15]
    s_mov_b32 s34, 1048576
    s_mov_b32 s35, 0x20000
    s_mov_b32 s10, s37
    s_mov_b32 s11, s71
    s_mov_b32 s37, 242
    s_add_u32 s66, s41, 67
    s_lshl_b32 s49, s40, 8
    s_add_u32 s49, s49, 524288
    s_add_u32 s2, s14, s49
    s_addc_u32 s3, s15, 0
    s_mul_i32 s69, s40, 3
    s_mov_b32 s39, 0
    s_mov_b32 s65, 0
    s_mov_b32 s70, 0
    s_mov_b32 s57, 0
    s_mov_b32 s58, 0
    s_mov_b32 s5, 0
    s_mov_b32 s93, 0
    s_mov_b32 s94, 0
    s_mov_b32 s95, 0
    s_mov_b32 s100, 0
    s_mov_b32 s38, 1
    s_mov_b32 s42, 484
    s_mov_b32 s44, 238
    s_lshl_b32 s47, s40, 13
    s_add_u32 s48, s41, 0
    s_and_b32 s48, s48, 7
    s_lshl_b32 s48, s48, 10
    s_add_u32 s24, s48, s47
    s_add_u32 s48, s41, 1
    s_and_b32 s48, s48, 7
    s_lshl_b32 s48, s48, 10
    s_add_u32 s25, s48, s47
    s_add_u32 s48, s41, 2
    s_and_b32 s48, s48, 7
    s_lshl_b32 s48, s48, 10
    s_add_u32 s26, s48, s47
    s_add_u32 s48, s41, 3
    s_and_b32 s48, s48, 7
    s_lshl_b32 s48, s48, 10
    s_add_u32 s27, s48, s47
    s_add_u32 s48, s41, 4
    s_and_b32 s48, s48, 7
    s_lshl_b32 s48, s48, 10
    s_add_u32 s28, s48, s47
    s_add_u32 s48, s41, 5
    s_and_b32 s48, s48, 7
    s_lshl_b32 s48, s48, 10
    s_add_u32 s29, s48, s47
    s_add_u32 s48, s41, 6
    s_and_b32 s48, s48, 7
    s_lshl_b32 s48, s48, 10
    s_add_u32 s30, s48, s47
    s_add_u32 s48, s41, 7
    s_and_b32 s48, s48, 7
    s_lshl_b32 s48, s48, 10
    s_add_u32 s31, s48, s47
    v_mov_b32 v17, v1
    v_lshlrev_b32 v153, 2, v153
    v_mov_b32 v151, v153
    v_mov_b32 v152, v153
    v_lshlrev_b32 v4, 4, v0
    v_and_b32 v9, 16, v0
    v_lshrrev_b32 v9, 1, v9
    v_add_u32 v8, v3, v9
    v_lshrrev_b32 v9, 5, v0
    v_lshl_add_u32 v18, v9, 7, v8
    v_lshl_add_u32 v19, v9, 2, v8
    v_and_b32 v8, 1, v5
    v_lshlrev_b32 v8, 4, v8
    v_mov_b32 v9, 0xffff
    v_lshlrev_b32 v9, v8, v9
    v_lshrrev_b32 v8, 1, v5
    v_cmp_eq_u32 vcc, 0, v8
    s_nop 1
    v_cndmask_b32 v10, 0, v9, vcc
    v_cmp_eq_u32 vcc, 1, v8
    s_nop 1
    v_cndmask_b32 v11, 0, v9, vcc
    v_cmp_eq_u32 vcc, 2, v8
    s_nop 1
    v_cndmask_b32 v12, 0, v9, vcc
    v_cmp_eq_u32 vcc, 3, v8
    s_nop 1
    v_cndmask_b32 v13, 0, v9, vcc
    v_mov_b32 v5, 0xff800000
    v_mov_b32 v154, 0xff800000
    v_mov_b32 v6, 0
    v_mov_b32 v7, 0
    v_mov_b32 v32, 0
    v_mov_b32 v33, 0
    v_mov_b32 v34, 0
    v_mov_b32 v35, 0
    v_mov_b32 v36, 0
    v_mov_b32 v37, 0
    v_mov_b32 v38, 0
    v_mov_b32 v39, 0
    v_mov_b32 v40, 0
    v_mov_b32 v41, 0
    v_mov_b32 v42, 0
    v_mov_b32 v43, 0
    s_waitcnt lgkmcnt(0)
    s_cmp_lg_u32 s67, 0
    s_cbranch_scc1 L_noinit
    v_mov_b32 v44, -1
    v_mov_b32 v45, -1
    v_mov_b32 v46, -1
    v_mov_b32 v47, -1
    v_mov_b32 v8, 0
    v_lshlrev_b32 v9, 2, v0
    buffer_store_dword v8, v9, s[32:35], s49 offen sc1
    buffer_store_dwordx4 v[44:47], v4, s[32:35], s24 offen sc1
    buffer_store_dwordx4 v[44:47], v4, s[32:35], s25 offen sc1
    buffer_store_dwordx4 v[44:47], v4, s[32:35], s26 offen sc1
    buffer_store_dwordx4 v[44:47], v4, s[32:35], s27 offen sc1
    buffer_store_dwordx4 v[44:47], v4, s[32:35], s28 offen sc1
    buffer_store_dwordx4 v[44:47], v4, s[32:35], s29 offen sc1
    buffer_store_dwordx4 v[44:47], v4, s[32:35], s30 offen sc1
    buffer_store_dwordx4 v[44:47], v4, s[32:35], s31 offen sc1
    s_mov_b32 s65, 0x10000
    s_mov_b32 s67, 0x10000
    s_waitcnt vmcnt(0)
    s_atomic_add s67, s[12:13], s64 glc
    s_mov_b32 s66, 0
L_noinit:
.p2align 6
L_loop:
    s_add_u32 s70, s70, 1
    s_cmp_eq_u32 s70, s66
    s_cbranch_scc1 L_event
L_seg0:
    s_cmp_gt_u32 s44, 2
    s_cbranch_scc0 L_rq0
L_nr0:
    s_mov_b32 s91, s43
    s_add_u32 s92, s43, s68
    s_sub_u32 s88, s88, 1
    s_cmp_eq_u32 s88, 0
    s_cselect_b32 s46, s90, s89
    s_cselect_b32 s88, 11, s88
    s_add_u32 s43, s43, s46
    s_cmp_eq_u32 s43, s56
    s_cselect_b32 s43, s55, s43
    s_cmp_lg_u32 s93, 0
    s_mov_b32 s93, s5
    s_cbranch_scc1 L_v0
    s_waitcnt vmcnt(21)
    v_dot2_f32_bf16 v14, v52, v20, 0
    v_dot2_f32_bf16 v15, v56, v24, 0
    v_dot2_f32_bf16 v16, v60, v28, 0
    v_dot2_f32_bf16 v14, v53, v21, v14
    v_dot2_f32_bf16 v15, v57, v25, v15
    v_dot2_f32_bf16 v16, v61, v29, v16
    v_dot2_f32_bf16 v14, v54, v22, v14
    v_dot2_f32_bf16 v15, v58, v26, v15
    v_dot2_f32_bf16 v16, v62, v30, v16
    v_dot2_f32_bf16 v14, v55, v23, v14
    v_dot2_f32_bf16 v15, v59, v27, v15
    v_dot2_f32_bf16 v16, v63, v31, v16
    buffer_load_dwordx4 v[52:55], v1, s[16:19], s91 offen offset:0 nt
    buffer_load_dwordx4 v[56:59], v1, s[16:19], s91 offen offset:128 nt
    buffer_load_dwordx4 v[60:63], v1, s[16:19], s91 offen offset:256 nt
    s_waitcnt vmcnt(21)
    v_dot2_f32_bf16 v148, v64, v20, 0
    v_dot2_f32_bf16 v149, v68, v24, 0
    v_dot2_f32_bf16 v150, v72, v28, 0
    v_dot2_f32_bf16 v148, v65, v21, v148
    v_dot2_f32_bf16 v149, v69, v25, v149
    v_dot2_f32_bf16 v150, v73, v29, v150
    v_dot2_f32_bf16 v148, v66, v22, v148
    v_dot2_f32_bf16 v149, v70, v26, v149
    v_dot2_f32_bf16 v150, v74, v30, v150
    v_dot2_f32_bf16 v148, v67, v23, v148
    v_dot2_f32_bf16 v149, v71, v27, v149
    v_dot2_f32_bf16 v150, v75, v31, v150
    buffer_load_dwordx4 v[64:67], v1, s[16:19], s92 offen offset:0 nt
    buffer_load_dwordx4 v[68:71], v1, s[16:19], s92 offen offset:128 nt
    buffer_load_dwordx4 v[72:75], v1, s[16:19], s92 offen offset:256 nt
    v_add_f32 v14, v14, v15
    v_add_f32 v148, v148, v149
    v_add_f32 v14, v14, v16
    v_add_f32 v148, v148, v150
    s_nop 0
    v_add_f32_dpp v14, v14, v14 quad_perm:[1,0,3,2] row_mask:0xf bank_mask:0xf
    v_add_f32_dpp v148, v148, v148 quad_perm:[1,0,3,2] row_mask:0xf bank_mask:0xf
    s_nop 0
    v_add_f32_dpp v14, v14, v14 quad_perm:[2,3,0,1] row_mask:0xf bank_mask:0xf
    v_add_f32_dpp v148, v148, v148 quad_perm:[2,3,0,1] row_mask:0xf bank_mask:0xf
    s_nop 0
    v_add_f32_dpp v14, v14, v14 row_half_mirror row_mask:0xf bank_mask:0xf
    v_add_f32_dpp v148, v148, v148 row_half_mirror row_mask:0xf bank_mask:0xf
    v_mov_b32 v152, v153
    v_max3_f32 v154, v154, v14, v148
    ds_write2_b32 v151, v14, v148 offset0:0 offset1:8
    s_mov_b32 s23, 0
    v_add_u32 v151, 64, v151
L_bnd0:
    s_cmp_gt_u32 s44, 1
    s_cbranch_scc0 L_dyn0
    s_sub_u32 s44, s44, 1
L_seg1:
    s_cmp_gt_u32 s44, 2
    s_cbranch_scc0 L_rq1
L_nr1:
    s_mov_b32 s91, s43
    s_add_u32 s92, s43, s68
    s_sub_u32 s88, s88, 1
    s_cmp_eq_u32 s88, 0
    s_cselect_b32 s46, s90, s89
    s_cselect_b32 s88, 11, s88
    s_add_u32 s43, s43, s46
    s_cmp_eq_u32 s43, s56
    s_cselect_b32 s43, s55, s43
    s_cmp_lg_u32 s94, 0
    s_mov_b32 s94, s5
    s_cbranch_scc1 L_v1
    s_waitcnt vmcnt(21)
    v_dot2_f32_bf16 v14, v76, v20, 0
    v_dot2_f32_bf16 v15, v80, v24, 0
    v_dot2_f32_bf16 v16, v84, v28, 0
    v_dot2_f32_bf16 v14, v77, v21, v14
    v_dot2_f32_bf16 v15, v81, v25, v15
    v_dot2_f32_bf16 v16, v85, v29, v16
    v_dot2_f32_bf16 v14, v78, v22, v14
    v_dot2_f32_bf16 v15, v82, v26, v15
    v_dot2_f32_bf16 v16, v86, v30, v16
    v_dot2_f32_bf16 v14, v79, v23, v14
    v_dot2_f32_bf16 v15, v83, v27, v15
    v_dot2_f32_bf16 v16, v87, v31, v16
    buffer_load_dwordx4 v[76:79], v1, s[16:19], s91 offen offset:0 nt
    buffer_load_dwordx4 v[80:83], v1, s[16:19], s91 offen offset:128 nt
    buffer_load_dwordx4 v[84:87], v1, s[16:19], s91 offen offset:256 nt
    s_waitcnt vmcnt(21)
    v_dot2_f32_bf16 v148, v88, v20, 0
    v_dot2_f32_bf16 v149, v92, v24, 0
    v_dot2_f32_bf16 v150, v96, v28, 0
    v_dot2_f32_bf16 v148, v89, v21, v148
    v_dot2_f32_bf16 v149, v93, v25, v149
    v_dot2_f32_bf16 v150, v97, v29, v150
    v_dot2_f32_bf16 v148, v90, v22, v148
    v_dot2_f32_bf16 v149, v94, v26, v149
    v_dot2_f32_bf16 v150, v98, v30, v150
    v_dot2_f32_bf16 v148, v91, v23, v148
    v_dot2_f32_bf16 v149, v95, v27, v149
    v_dot2_f32_bf16 v150, v99, v31, v150
    buffer_load_dwordx4 v[88:91], v1, s[16:19], s92 offen offset:0 nt
    buffer_load_dwordx4 v[92:95], v1, s[16:19], s92 offen offset:128 nt
    buffer_load_dwordx4 v[96:99], v1, s[16:19], s92 offen offset:256 nt
    v_add_f32 v14, v14, v15
    v_add_f32 v148, v148, v149
    v_add_f32 v14, v14, v16
    v_add_f32 v148, v148, v150
    s_nop 0
    v_add_f32_dpp v14, v14, v14 quad_perm:[1,0,3,2] row_mask:0xf bank_mask:0xf
    v_add_f32_dpp v148, v148, v148 quad_perm:[1,0,3,2] row_mask:0xf bank_mask:0xf
    s_nop 0
    v_add_f32_dpp v14, v14, v14 quad_perm:[2,3,0,1] row_mask:0xf bank_mask:0xf
    v_add_f32_dpp v148, v148, v148 quad_perm:[2,3,0,1] row_mask:0xf bank_mask:0xf
    s_nop 0
    v_add_f32_dpp v14, v14, v14 row_half_mirror row_mask:0xf bank_mask:0xf
    v_add_f32_dpp v148, v148, v148 row_half_mirror row_mask:0xf bank_mask:0xf
    v_mov_b32 v152, v153
    v_max3_f32 v154, v154, v14, v148
    ds_write2_b32 v151, v14, v148 offset0:0 offset1:8
    s_mov_b32 s23, 0
    v_add_u32 v151, 64, v151
L_bnd1:
    s_cmp_gt_u32 s44, 1
    s_cbranch_scc0 L_dyn1
    s_sub_u32 s44, s44, 1
L_seg2:
    s_cmp_gt_u32 s44, 2
    s_cbranch_scc0 L_rq2
L_nr2:
    s_mov_b32 s91, s43
    s_add_u32 s92, s43, s68
    s_sub_u32 s88, s88, 1
    s_cmp_eq_u32 s88, 0
    s_cselect_b32 s46, s90, s89
    s_cselect_b32 s88, 11, s88
    s_add_u32 s43, s43, s46
    s_cmp_eq_u32 s43, s56
    s_cselect_b32 s43, s55, s43
    s_cmp_lg_u32 s95, 0
    s_mov_b32 s95, s5
    s_cbranch_scc1 L_v2
    s_waitcnt vmcnt(21)
    v_dot2_f32_bf16 v14, v100, v20, 0
    v_dot2_f32_bf16 v15, v104, v24, 0
    v_dot2_f32_bf16 v16, v108, v28, 0
    v_dot2_f32_bf16 v14, v101, v21, v14
    v_dot2_f32_bf16 v15, v105, v25, v15
    v_dot2_f32_bf16 v16, v109, v29, v16
    v_dot2_f32_bf16 v14, v102, v22, v14
    v_dot2_f32_bf16 v15, v106, v26, v15
    v_dot2_f32_bf16 v16, v110, v30, v16
    v_dot2_f32_bf16 v14, v103, v23, v14
    v_dot2_f32_bf16 v15, v107, v27, v15
    v_dot2_f32_bf16 v16, v111, v31, v16
    buffer_load_dwordx4 v[100:103], v1, s[16:19], s91 offen offset:0 nt
    buffer_load_dwordx4 v[104:107], v1, s[16:19], s91 offen offset:128 nt
    buffer_load_dwordx4 v[108:111], v1, s[16:19], s91 offen offset:256 nt
    s_waitcnt vmcnt(21)
    v_dot2_f32_bf16 v148, v112, v20, 0
    v_dot2_f32_bf16 v149, v116, v24, 0
    v_dot2_f32_bf16 v150, v120, v28, 0
    v_dot2_f32_bf16 v148, v113, v21, v148
    v_dot2_f32_bf16 v149, v117, v25, v149
    v_dot2_f32_bf16 v150, v121, v29, v150
    v_dot2_f32_bf16 v148, v114, v22, v148
    v_dot2_f32_bf16 v149, v118, v26, v149
    v_dot2_f32_bf16 v150, v122, v30, v150
    v_dot2_f32_bf16 v148, v115, v23, v148
    v_dot2_f32_bf16 v149, v119, v27, v149
    v_dot2_f32_bf16 v150, v123, v31, v150
    buffer_load_dwordx4 v[112:115], v1, s[16:19], s92 offen offset:0 nt
    buffer_load_dwordx4 v[116:119], v1, s[16:19], s92 offen offset:128 nt
    buffer_load_dwordx4 v[120:123], v1, s[16:19], s92 offen offset:256 nt
    v_add_f32 v14, v14, v15
    v_add_f32 v148, v148, v149
    v_add_f32 v14, v14, v16
    v_add_f32 v148, v148, v150
    s_nop 0
    v_add_f32_dpp v14, v14, v14 quad_perm:[1,0,3,2] row_mask:0xf bank_mask:0xf
    v_add_f32_dpp v148, v148, v148 quad_perm:[1,0,3,2] row_mask:0xf bank_mask:0xf
    s_nop 0
    v_add_f32_dpp v14, v14, v14 quad_perm:[2,3,0,1] row_mask:0xf bank_mask:0xf
    v_add_f32_dpp v148, v148, v148 quad_perm:[2,3,0,1] row_mask:0xf bank_mask:0xf
    s_nop 0
    v_add_f32_dpp v14, v14, v14 row_half_mirror row_mask:0xf bank_mask:0xf
    v_add_f32_dpp v148, v148, v148 row_half_mirror row_mask:0xf bank_mask:0xf
    v_mov_b32 v152, v153
    v_max3_f32 v154, v154, v14, v148
    ds_write2_b32 v151, v14, v148 offset0:0 offset1:8
    s_mov_b32 s23, 0
    v_add_u32 v151, 64, v151
L_bnd2:
    s_cmp_gt_u32 s44, 1
    s_cbranch_scc0 L_dyn2
    s_sub_u32 s44, s44, 1
L_seg3:
    s_cmp_gt_u32 s44, 2
    s_cbranch_scc0 L_rq3
L_nr3:
    s_mov_b32 s91, s43
    s_add_u32 s92, s43, s68
    s_sub_u32 s88, s88, 1
    s_cmp_eq_u32 s88, 0
    s_cselect_b32 s46, s90, s89
    s_cselect_b32 s88, 11, s88
    s_add_u32 s43, s43, s46
    s_cmp_eq_u32 s43, s56
    s_cselect_b32 s43, s55, s43
    s_cmp_lg_u32 s100, 0
    s_mov_b32 s100, s5
    s_cbranch_scc1 L_v3
    s_waitcnt vmcnt(21)
    v_dot2_f32_bf16 v14, v124, v20, 0
    v_dot2_f32_bf16 v15, v128, v24, 0
    v_dot2_f32_bf16 v16, v132, v28, 0
    v_dot2_f32_bf16 v14, v125, v21, v14
    v_dot2_f32_bf16 v15, v129, v25, v15
    v_dot2_f32_bf16 v16, v133, v29, v16
    v_dot2_f32_bf16 v14, v126, v22, v14
    v_dot2_f32_bf16 v15, v130, v26, v15
    v_dot2_f32_bf16 v16, v134, v30, v16
    v_dot2_f32_bf16 v14, v127, v23, v14
    v_dot2_f32_bf16 v15, v131, v27, v15
    v_dot2_f32_bf16 v16, v135, v31, v16
    buffer_load_dwordx4 v[124:127], v1, s[16:19], s91 offen offset:0 nt
    buffer_load_dwordx4 v[128:131], v1, s[16:19], s91 offen offset:128 nt
    buffer_load_dwordx4 v[132:135], v1, s[16:19], s91 offen offset:256 nt
    s_waitcnt vmcnt(21)
    v_dot2_f32_bf16 v148, v136, v20, 0
    v_dot2_f32_bf16 v149, v140, v24, 0
    v_dot2_f32_bf16 v150, v144, v28, 0
    v_dot2_f32_bf16 v148, v137, v21, v148
    v_dot2_f32_bf16 v149, v141, v25, v149
    v_dot2_f32_bf16 v150, v145, v29, v150
    v_dot2_f32_bf16 v148, v138, v22, v148
    v_dot2_f32_bf16 v149, v142, v26, v149
    v_dot2_f32_bf16 v150, v146, v30, v150
    v_dot2_f32_bf16 v148, v139, v23, v148
    v_dot2_f32_bf16 v149, v143, v27, v149
    v_dot2_f32_bf16 v150, v147, v31, v150
    buffer_load_dwordx4 v[136:139], v1, s[16:19], s92 offen offset:0 nt
    buffer_load_dwordx4 v[140:143], v1, s[16:19], s92 offen offset:128 nt
    buffer_load_dwordx4 v[144:147], v1, s[16:19], s92 offen offset:256 nt
    v_add_f32 v14, v14, v15
    v_add_f32 v148, v148, v149
    v_add_f32 v14, v14, v16
    v_add_f32 v148, v148, v150
    s_nop 0
    v_add_f32_dpp v14, v14, v14 quad_perm:[1,0,3,2] row_mask:0xf bank_mask:0xf
    v_add_f32_dpp v148, v148, v148 quad_perm:[1,0,3,2] row_mask:0xf bank_mask:0xf
    s_nop 0
    v_add_f32_dpp v14, v14, v14 quad_perm:[2,3,0,1] row_mask:0xf bank_mask:0xf
    v_add_f32_dpp v148, v148, v148 quad_perm:[2,3,0,1] row_mask:0xf bank_mask:0xf
    s_nop 0
    v_add_f32_dpp v14, v14, v14 row_half_mirror row_mask:0xf bank_mask:0xf
    v_add_f32_dpp v148, v148, v148 row_half_mirror row_mask:0xf bank_mask:0xf
    v_mov_b32 v152, v153
    v_max3_f32 v154, v154, v14, v148
    ds_write2_b32 v151, v14, v148 offset0:0 offset1:8
    s_mov_b32 s23, 0
    v_add_u32 v151, 64, v151
L_bnd3:
    s_cmp_gt_u32 s44, 1
    s_cbranch_scc0 L_dyn3
    s_sub_u32 s44, s44, 1
    s_branch L_loop
L_v0:
    ds_read2_b32 v[14:15], v152 offset0:0 offset1:8
    v_add_u32 v152, 64, v152
    v_mov_b32 v151, v153
    s_cmp_eq_u32 s23, 0
    s_cbranch_scc1 L_rare0
L_back0:
    s_waitcnt lgkmcnt(0)
    v_fma_f32 v14, v14, s45, -v6
    v_fma_f32 v15, v15, s45, -v6
    v_exp_f32 v14, v14
    v_exp_f32 v15, v15
    v_add_f32 v7, v7, v14
    v_add_f32 v7, v7, v15
    v_cvt_pk_bf16_f32 v14, v14, v14
    v_cvt_pk_bf16_f32 v15, v15, v15
    v_and_b32 v44, v14, v10
    v_and_b32 v45, v14, v11
    v_and_b32 v46, v14, v12
    v_and_b32 v47, v14, v13
    v_and_b32 v48, v15, v10
    v_and_b32 v49, v15, v11
    v_and_b32 v50, v15, v12
    v_and_b32 v51, v15, v13
    s_waitcnt vmcnt(21)
    v_mfma_f32_16x16x32_bf16 v[32:35], v[44:47], v[52:55], v[32:35]
    v_mfma_f32_16x16x32_bf16 v[36:39], v[44:47], v[56:59], v[36:39]
    v_mfma_f32_16x16x32_bf16 v[40:43], v[44:47], v[60:63], v[40:43]
    buffer_load_dwordx4 v[52:55], v1, s[16:19], s91 offen offset:0 nt
    buffer_load_dwordx4 v[56:59], v1, s[16:19], s91 offen offset:128 nt
    buffer_load_dwordx4 v[60:63], v1, s[16:19], s91 offen offset:256 nt
    s_waitcnt vmcnt(21)
    v_mfma_f32_16x16x32_bf16 v[32:35], v[48:51], v[64:67], v[32:35]
    v_mfma_f32_16x16x32_bf16 v[36:39], v[48:51], v[68:71], v[36:39]
    v_mfma_f32_16x16x32_bf16 v[40:43], v[48:51], v[72:75], v[40:43]
    buffer_load_dwordx4 v[64:67], v1, s[16:19], s92 offen offset:0 nt
    buffer_load_dwordx4 v[68:71], v1, s[16:19], s92 offen offset:128 nt
    buffer_load_dwordx4 v[72:75], v1, s[16:19], s92 offen offset:256 nt
    s_branch L_bnd0
L_v1:
    ds_read2_b32 v[14:15], v152 offset0:0 offset1:8
    v_add_u32 v152, 64, v152
    v_mov_b32 v151, v153
    s_cmp_eq_u32 s23, 0
    s_cbranch_scc1 L_rare1
L_back1:
    s_waitcnt lgkmcnt(0)
    v_fma_f32 v14, v14, s45, -v6
    v_fma_f32 v15, v15, s45, -v6
    v_exp_f32 v14, v14
    v_exp_f32 v15, v15
    v_add_f32 v7, v7, v14
    v_add_f32 v7, v7, v15
    v_cvt_pk_bf16_f32 v14, v14, v14
    v_cvt_pk_bf16_f32 v15, v15, v15
    v_and_b32 v44, v14, v10
    v_and_b32 v45, v14, v11
    v_and_b32 v46, v14, v12
    v_and_b32 v47, v14, v13
    v_and_b32 v48, v15, v10
    v_and_b32 v49, v15, v11
    v_and_b32 v50, v15, v12
    v_and_b32 v51, v15, v13
    s_waitcnt vmcnt(21)
    v_mfma_f32_16x16x32_bf16 v[32:35], v[44:47], v[76:79], v[32:35]
    v_mfma_f32_16x16x32_bf16 v[36:39], v[44:47], v[80:83], v[36:39]
    v_mfma_f32_16x16x32_bf16 v[40:43], v[44:47], v[84:87], v[40:43]
    buffer_load_dwordx4 v[76:79], v1, s[16:19], s91 offen offset:0 nt
    buffer_load_dwordx4 v[80:83], v1, s[16:19], s91 offen offset:128 nt
    buffer_load_dwordx4 v[84:87], v1, s[16:19], s91 offen offset:256 nt
    s_waitcnt vmcnt(21)
    v_mfma_f32_16x16x32_bf16 v[32:35], v[48:51], v[88:91], v[32:35]
    v_mfma_f32_16x16x32_bf16 v[36:39], v[48:51], v[92:95], v[36:39]
    v_mfma_f32_16x16x32_bf16 v[40:43], v[48:51], v[96:99], v[40:43]
    buffer_load_dwordx4 v[88:91], v1, s[16:19], s92 offen offset:0 nt
    buffer_load_dwordx4 v[92:95], v1, s[16:19], s92 offen offset:128 nt
    buffer_load_dwordx4 v[96:99], v1, s[16:19], s92 offen offset:256 nt
    s_branch L_bnd1
L_v2:
    ds_read2_b32 v[14:15], v152 offset0:0 offset1:8
    v_add_u32 v152, 64, v152
    v_mov_b32 v151, v153
    s_cmp_eq_u32 s23, 0
    s_cbranch_scc1 L_rare2
L_back2:
    s_waitcnt lgkmcnt(0)
    v_fma_f32 v14, v14, s45, -v6
    v_fma_f32 v15, v15, s45, -v6
    v_exp_f32 v14, v14
    v_exp_f32 v15, v15
    v_add_f32 v7, v7, v14
    v_add_f32 v7, v7, v15
    v_cvt_pk_bf16_f32 v14, v14, v14
    v_cvt_pk_bf16_f32 v15, v15, v15
    v_and_b32 v44, v14, v10
    v_and_b32 v45, v14, v11
    v_and_b32 v46, v14, v12
    v_and_b32 v47, v14, v13
    v_and_b32 v48, v15, v10
    v_and_b32 v49, v15, v11
    v_and_b32 v50, v15, v12
    v_and_b32 v51, v15, v13
    s_waitcnt vmcnt(21)
    v_mfma_f32_16x16x32_bf16 v[32:35], v[44:47], v[100:103], v[32:35]
    v_mfma_f32_16x16x32_bf16 v[36:39], v[44:47], v[104:107], v[36:39]
    v_mfma_f32_16x16x32_bf16 v[40:43], v[44:47], v[108:111], v[40:43]
    buffer_load_dwordx4 v[100:103], v1, s[16:19], s91 offen offset:0 nt
    buffer_load_dwordx4 v[104:107], v1, s[16:19], s91 offen offset:128 nt
    buffer_load_dwordx4 v[108:111], v1, s[16:19], s91 offen offset:256 nt
    s_waitcnt vmcnt(21)
    v_mfma_f32_16x16x32_bf16 v[32:35], v[48:51], v[112:115], v[32:35]
    v_mfma_f32_16x16x32_bf16 v[36:39], v[48:51], v[116:119], v[36:39]
    v_mfma_f32_16x16x32_bf16 v[40:43], v[48:51], v[120:123], v[40:43]
    buffer_load_dwordx4 v[112:115], v1, s[16:19], s92 offen offset:0 nt
    buffer_load_dwordx4 v[116:119], v1, s[16:19], s92 offen offset:128 nt
    buffer_load_dwordx4 v[120:123], v1, s[16:19], s92 offen offset:256 nt
    s_branch L_bnd2
L_v3:
    ds_read2_b32 v[14:15], v152 offset0:0 offset1:8
    v_add_u32 v152, 64, v152
    v_mov_b32 v151, v153
    s_cmp_eq_u32 s23, 0
    s_cbranch_scc1 L_rare3
L_back3:
    s_waitcnt lgkmcnt(0)
    v_fma_f32 v14, v14, s45, -v6
    v_fma_f32 v15, v15, s45, -v6
    v_exp_f32 v14, v14
    v_exp_f32 v15, v15
    v_add_f32 v7, v7, v14
    v_add_f32 v7, v7, v15
    v_cvt_pk_bf16_f32 v14, v14, v14
    v_cvt_pk_bf16_f32 v15, v15, v15
    v_and_b32 v44, v14, v10
    v_and_b32 v45, v14, v11
    v_and_b32 v46, v14, v12
    v_and_b32 v47, v14, v13
    v_and_b32 v48, v15, v10
    v_and_b32 v49, v15, v11
    v_and_b32 v50, v15, v12
    v_and_b32 v51, v15, v13
    s_waitcnt vmcnt(21)
    v_mfma_f32_16x16x32_bf16 v[32:35], v[44:47], v[124:127], v[32:35]
    v_mfma_f32_16x16x32_bf16 v[36:39], v[44:47], v[128:131], v[36:39]
    v_mfma_f32_16x16x32_bf16 v[40:43], v[44:47], v[132:135], v[40:43]
    buffer_load_dwordx4 v[124:127], v1, s[16:19], s91 offen offset:0 nt
    buffer_load_dwordx4 v[128:131], v1, s[16:19], s91 offen offset:128 nt
    buffer_load_dwordx4 v[132:135], v1, s[16:19], s91 offen offset:256 nt
    s_waitcnt vmcnt(21)
    v_mfma_f32_16x16x32_bf16 v[32:35], v[48:51], v[136:139], v[32:35]
    v_mfma_f32_16x16x32_bf16 v[36:39], v[48:51], v[140:143], v[36:39]
    v_mfma_f32_16x16x32_bf16 v[40:43], v[48:51], v[144:147], v[40:43]
    buffer_load_dwordx4 v[136:139], v1, s[16:19], s92 offen offset:0 nt
    buffer_load_dwordx4 v[140:143], v1, s[16:19], s92 offen offset:128 nt
    buffer_load_dwordx4 v[144:147], v1, s[16:19], s92 offen offset:256 nt
    s_branch L_bnd3
L_rq0:
    s_cmp_lg_u32 s38, 0
    s_cbranch_scc1 L_nr0
    s_mov_b32 s38, 1
    s_waitcnt lgkmcnt(0)
    s_cmp_ge_u32 s65, 0x10000
    s_cbranch_scc0 L_chk0
L_req0:
    s_mov_b32 s20, 1
    s_mov_b32 s21, s42
    s_atomic_add_x2 s[20:21], s[2:3], 0x0 glc
    s_branch L_nr0
L_dyn0:
    s_cmp_lg_u32 s5, 0
    s_cbranch_scc1 L_nxt0
    s_mov_b64 s[16:17], s[8:9]
    s_mov_b32 s43, s10
    s_mov_b32 s88, s11
    s_mov_b32 s44, s37
    s_mov_b32 s5, 1
    s_mov_b32 s38, 0
    s_branch L_seg1
L_nxt0:
    s_cmp_lg_u32 s57, 0
    s_cbranch_scc1 L_fin
    s_waitcnt lgkmcnt(0)
    s_mov_b32 s54, s20
    s_cmp_ge_u32 s54, 24
    s_cbranch_scc1 L_last0
    s_mov_b64 s[16:17], s[6:7]
    s_mov_b32 s5, 0
    s_cmp_eq_u32 s54, 23
    s_cbranch_scc1 L_plain0
    s_cmp_gt_u32 s54, 23
    s_subb_u32 s54, s54, 0
    s_add_u32 s55, s59, 11894784
    s_add_u32 s56, s59, 12570624
    s_mov_b32 s68, 33792
    v_mov_b32 v1, v17
    s_mov_b32 s89, 3072
    s_mov_b32 s90, 36864
    s_mov_b32 s44, 2
    s_mov_b32 s47, 0x40
    s_cmp_lt_u32 s54, 16
    s_cselect_b32 s44, 4, s44
    s_cselect_b32 s47, 0x20, s47
    s_cmp_lt_u32 s54, 8
    s_cselect_b32 s44, 8, s44
    s_cselect_b32 s47, 0x0, s47
    s_mul_i32 s54, s54, s44
    s_add_u32 s54, s54, s47
    s_add_u32 s54, s54, s69
    s_sub_u32 s47, s54, 110
    s_cmp_ge_u32 s54, 110
    s_cselect_b32 s54, s47, s54
    s_mul_hi_u32 s48, s54, 390451573
    s_mul_i32 s48, s48, 11
    s_sub_u32 s54, s54, s48
    s_sub_u32 s88, 11, s54
    s_mul_i32 s48, s48, 6144
    s_mul_i32 s54, s54, 3072
    s_add_u32 s43, s55, s48
    s_add_u32 s43, s43, s54
L_set0:
    s_mov_b32 s10, s43
    s_mov_b32 s11, s88
    s_mov_b32 s37, s44
    s_lshl_b32 s42, s44, 1
    s_branch L_seg1
L_plain0:
    v_mov_b32 v1, v2
    s_mov_b32 s89, 3072
    s_mov_b32 s90, 3072
    s_add_u32 s43, s59, 12570624
    s_mov_b32 s56, -1
    s_mov_b32 s68, 6144
    s_mov_b32 s44, 2
    s_branch L_set0
L_last0:
    s_mov_b32 s71, s21
    s_mov_b32 s18, 0
    s_mov_b32 s43, 0
    s_mov_b32 s68, 0
    s_mov_b32 s57, 1
    s_mov_b32 s44, 4
    s_branch L_seg1
L_chk0:
    s_mov_b32 s65, 1
    s_atomic_add s65, s[12:13], s64 glc
    s_waitcnt lgkmcnt(0)
    s_cmp_lg_u32 s65, 0
    s_cbranch_scc1 L_spin0
    v_mov_b32 v44, -1
    v_mov_b32 v45, -1
    v_mov_b32 v46, -1
    v_mov_b32 v47, -1
    v_mov_b32 v8, 0
    v_lshlrev_b32 v9, 2, v0
    buffer_store_dword v8, v9, s[32:35], s49 offen sc1
    buffer_store_dwordx4 v[44:47], v4, s[32:35], s24 offen sc1
    buffer_store_dwordx4 v[44:47], v4, s[32:35], s25 offen sc1
    buffer_store_dwordx4 v[44:47], v4, s[32:35], s26 offen sc1
    buffer_store_dwordx4 v[44:47], v4, s[32:35], s27 offen sc1
    buffer_store_dwordx4 v[44:47], v4, s[32:35], s28 offen sc1
    buffer_store_dwordx4 v[44:47], v4, s[32:35], s29 offen sc1
    buffer_store_dwordx4 v[44:47], v4, s[32:35], s30 offen sc1
    buffer_store_dwordx4 v[44:47], v4, s[32:35], s31 offen sc1
    s_mov_b32 s65, 0x10000
    s_mov_b32 s67, 0x10000
    s_waitcnt vmcnt(0)
    s_atomic_add s67, s[12:13], s64 glc
    s_waitcnt lgkmcnt(0)
    s_branch L_req0
L_spin0:
    s_cmp_ge_u32 s65, 0x10000
    s_cbranch_scc1 L_req0
    s_add_u32 s58, s58, 1
    s_cmp_ge_u32 s58, 0x10000
    s_cbranch_scc1 L_giveup0
    s_sleep 2
    s_mov_b32 s65, 0
    s_atomic_add s65, s[12:13], s64 glc
    s_waitcnt lgkmcnt(0)
    s_branch L_spin0
L_giveup0:
    s_mov_b32 s65, 0x10000
    s_branch L_req0
L_rq1:
    s_cmp_lg_u32 s38, 0
    s_cbranch_scc1 L_nr1
    s_mov_b32 s38, 1
    s_waitcnt lgkmcnt(0)
    s_cmp_ge_u32 s65, 0x10000
    s_cbranch_scc0 L_chk1
L_req1:
    s_mov_b32 s20, 1
    s_mov_b32 s21, s42
    s_atomic_add_x2 s[20:21], s[2:3], 0x0 glc
    s_branch L_nr1
L_dyn1:
    s_cmp_lg_u32 s5, 0
    s_cbranch_scc1 L_nxt1
    s_mov_b64 s[16:17], s[8:9]
    s_mov_b32 s43, s10
    s_mov_b32 s88, s11
    s_mov_b32 s44, s37
    s_mov_b32 s5, 1
    s_mov_b32 s38, 0
    s_branch L_seg2
L_nxt1:
    s_cmp_lg_u32 s57, 0
    s_cbranch_scc1 L_fin
    s_waitcnt lgkmcnt(0)
    s_mov_b32 s54, s20
    s_cmp_ge_u32 s54, 24
    s_cbranch_scc1 L_last1
    s_mov_b64 s[16:17], s[6:7]
    s_mov_b32 s5, 0
    s_cmp_eq_u32 s54, 23
    s_cbranch_scc1 L_plain1
    s_cmp_gt_u32 s54, 23
    s_subb_u32 s54, s54, 0
    s_add_u32 s55, s59, 11894784
    s_add_u32 s56, s59, 12570624
    s_mov_b32 s68, 33792
    v_mov_b32 v1, v17
    s_mov_b32 s89, 3072
    s_mov_b32 s90, 36864
    s_mov_b32 s44, 2
    s_mov_b32 s47, 0x40
    s_cmp_lt_u32 s54, 16
    s_cselect_b32 s44, 4, s44
    s_cselect_b32 s47, 0x20, s47
    s_cmp_lt_u32 s54, 8
    s_cselect_b32 s44, 8, s44
    s_cselect_b32 s47, 0x0, s47
    s_mul_i32 s54, s54, s44
    s_add_u32 s54, s54, s47
    s_add_u32 s54, s54, s69
    s_sub_u32 s47, s54, 110
    s_cmp_ge_u32 s54, 110
    s_cselect_b32 s54, s47, s54
    s_mul_hi_u32 s48, s54, 390451573
    s_mul_i32 s48, s48, 11
    s_sub_u32 s54, s54, s48
    s_sub_u32 s88, 11, s54
    s_mul_i32 s48, s48, 6144
    s_mul_i32 s54, s54, 3072
    s_add_u32 s43, s55, s48
    s_add_u32 s43, s43, s54
L_set1:
    s_mov_b32 s10, s43
    s_mov_b32 s11, s88
    s_mov_b32 s37, s44
    s_lshl_b32 s42, s44, 1
    s_branch L_seg2
L_plain1:
    v_mov_b32 v1, v2
    s_mov_b32 s89, 3072
    s_mov_b32 s90, 3072
    s_add_u32 s43, s59, 12570624
    s_mov_b32 s56, -1
    s_mov_b32 s68, 6144
    s_mov_b32 s44, 2
    s_branch L_set1
L_last1:
    s_mov_b32 s71, s21
    s_mov_b32 s18, 0
    s_mov_b32 s43, 0
    s_mov_b32 s68, 0
    s_mov_b32 s57, 1
    s_mov_b32 s44, 4
    s_branch L_seg2
L_chk1:
    s_mov_b32 s65, 1
    s_atomic_add s65, s[12:13], s64 glc
    s_waitcnt lgkmcnt(0)
    s_cmp_lg_u32 s65, 0
    s_cbranch_scc1 L_spin1
    v_mov_b32 v44, -1
    v_mov_b32 v45, -1
    v_mov_b32 v46, -1
    v_mov_b32 v47, -1
    v_mov_b32 v8, 0
    v_lshlrev_b32 v9, 2, v0
    buffer_store_dword v8, v9, s[32:35], s49 offen sc1
    buffer_store_dwordx4 v[44:47], v4, s[32:35], s24 offen sc1
    buffer_store_dwordx4 v[44:47], v4, s[32:35], s25 offen sc1
    buffer_store_dwordx4 v[44:47], v4, s[32:35], s26 offen sc1
    buffer_store_dwordx4 v[44:47], v4, s[32:35], s27 offen sc1
    buffer_store_dwordx4 v[44:47], v4, s[32:35], s28 offen sc1
    buffer_store_dwordx4 v[44:47], v4, s[32:35], s29 offen sc1
    buffer_store_dwordx4 v[44:47], v4, s[32:35], s30 offen sc1
    buffer_store_dwordx4 v[44:47], v4, s[32:35], s31 offen sc1
    s_mov_b32 s65, 0x10000
    s_mov_b32 s67, 0x10000
    s_waitcnt vmcnt(0)
    s_atomic_add s67, s[12:13], s64 glc
    s_waitcnt lgkmcnt(0)
    s_branch L_req1
L_spin1:
    s_cmp_ge_u32 s65, 0x10000
    s_cbranch_scc1 L_req1
    s_add_u32 s58, s58, 1
    s_cmp_ge_u32 s58, 0x10000
    s_cbranch_scc1 L_giveup1
    s_sleep 2
    s_mov_b32 s65, 0
    s_atomic_add s65, s[12:13], s64 glc
    s_waitcnt lgkmcnt(0)
    s_branch L_spin1
L_giveup1:
    s_mov_b32 s65, 0x10000
    s_branch L_req1
L_rq2:
    s_cmp_lg_u32 s38, 0
    s_cbranch_scc1 L_nr2
    s_mov_b32 s38, 1
    s_waitcnt lgkmcnt(0)
    s_cmp_ge_u32 s65, 0x10000
    s_cbranch_scc0 L_chk2
L_req2:
    s_mov_b32 s20, 1
    s_mov_b32 s21, s42
    s_atomic_add_x2 s[20:21], s[2:3], 0x0 glc
    s_branch L_nr2
L_dyn2:
    s_cmp_lg_u32 s5, 0
    s_cbranch_scc1 L_nxt2
    s_mov_b64 s[16:17], s[8:9]
    s_mov_b32 s43, s10
    s_mov_b32 s88, s11
    s_mov_b32 s44, s37
    s_mov_b32 s5, 1
    s_mov_b32 s38, 0
    s_branch L_seg3
L_nxt2:
    s_cmp_lg_u32 s57, 0
    s_cbranch_scc1 L_fin
    s_waitcnt lgkmcnt(0)
    s_mov_b32 s54, s20
    s_cmp_ge_u32 s54, 24
    s_cbranch_scc1 L_last2
    s_mov_b64 s[16:17], s[6:7]
    s_mov_b32 s5, 0
    s_cmp_eq_u32 s54, 23
    s_cbranch_scc1 L_plain2
    s_cmp_gt_u32 s54, 23
    s_subb_u32 s54, s54, 0
    s_add_u32 s55, s59, 11894784
    s_add_u32 s56, s59, 12570624
    s_mov_b32 s68, 33792
    v_mov_b32 v1, v17
    s_mov_b32 s89, 3072
    s_mov_b32 s90, 36864
    s_mov_b32 s44, 2
    s_mov_b32 s47, 0x40
    s_cmp_lt_u32 s54, 16
    s_cselect_b32 s44, 4, s44
    s_cselect_b32 s47, 0x20, s47
    s_cmp_lt_u32 s54, 8
    s_cselect_b32 s44, 8, s44
    s_cselect_b32 s47, 0x0, s47
    s_mul_i32 s54, s54, s44
    s_add_u32 s54, s54, s47
    s_add_u32 s54, s54, s69
    s_sub_u32 s47, s54, 110
    s_cmp_ge_u32 s54, 110
    s_cselect_b32 s54, s47, s54
    s_mul_hi_u32 s48, s54, 390451573
    s_mul_i32 s48, s48, 11
    s_sub_u32 s54, s54, s48
    s_sub_u32 s88, 11, s54
    s_mul_i32 s48, s48, 6144
    s_mul_i32 s54, s54, 3072
    s_add_u32 s43, s55, s48
    s_add_u32 s43, s43, s54
L_set2:
    s_mov_b32 s10, s43
    s_mov_b32 s11, s88
    s_mov_b32 s37, s44
    s_lshl_b32 s42, s44, 1
    s_branch L_seg3
L_plain2:
    v_mov_b32 v1, v2
    s_mov_b32 s89, 3072
    s_mov_b32 s90, 3072
    s_add_u32 s43, s59, 12570624
    s_mov_b32 s56, -1
    s_mov_b32 s68, 6144
    s_mov_b32 s44, 2
    s_branch L_set2
L_last2:
    s_mov_b32 s71, s21
    s_mov_b32 s18, 0
    s_mov_b32 s43, 0
    s_mov_b32 s68, 0
    s_mov_b32 s57, 1
    s_mov_b32 s44, 4
    s_branch L_seg3
L_chk2:
    s_mov_b32 s65, 1
    s_atomic_add s65, s[12:13], s64 glc
    s_waitcnt lgkmcnt(0)
    s_cmp_lg_u32 s65, 0
    s_cbranch_scc1 L_spin2
    v_mov_b32 v44, -1
    v_mov_b32 v45, -1
    v_mov_b32 v46, -1
    v_mov_b32 v47, -1
    v_mov_b32 v8, 0
    v_lshlrev_b32 v9, 2, v0
    buffer_store_dword v8, v9, s[32:35], s49 offen sc1
    buffer_store_dwordx4 v[44:47], v4, s[32:35], s24 offen sc1
    buffer_store_dwordx4 v[44:47], v4, s[32:35], s25 offen sc1
    buffer_store_dwordx4 v[44:47], v4, s[32:35], s26 offen sc1
    buffer_store_dwordx4 v[44:47], v4, s[32:35], s27 offen sc1
    buffer_store_dwordx4 v[44:47], v4, s[32:35], s28 offen sc1
    buffer_store_dwordx4 v[44:47], v4, s[32:35], s29 offen sc1
    buffer_store_dwordx4 v[44:47], v4, s[32:35], s30 offen sc1
    buffer_store_dwordx4 v[44:47], v4, s[32:35], s31 offen sc1
    s_mov_b32 s65, 0x10000
    s_mov_b32 s67, 0x10000
    s_waitcnt vmcnt(0)
    s_atomic_add s67, s[12:13], s64 glc
    s_waitcnt lgkmcnt(0)
    s_branch L_req2
L_spin2:
    s_cmp_ge_u32 s65, 0x10000
    s_cbranch_scc1 L_req2
    s_add_u32 s58, s58, 1
    s_cmp_ge_u32 s58, 0x10000
    s_cbranch_scc1 L_giveup2
    s_sleep 2
    s_mov_b32 s65, 0
    s_atomic_add s65, s[12:13], s64 glc
    s_waitcnt lgkmcnt(0)
    s_branch L_spin2
L_giveup2:
    s_mov_b32 s65, 0x10000
    s_branch L_req2
L_rq3:
    s_cmp_lg_u32 s38, 0
    s_cbranch_scc1 L_nr3
    s_mov_b32 s38, 1
    s_waitcnt lgkmcnt(0)
    s_cmp_ge_u32 s65, 0x10000
    s_cbranch_scc0 L_chk3
L_req3:
    s_mov_b32 s20, 1
    s_mov_b32 s21, s42
    s_atomic_add_x2 s[20:21], s[2:3], 0x0 glc
    s_branch L_nr3
L_dyn3:
    s_cmp_lg_u32 s5, 0
    s_cbranch_scc1 L_nxt3
    s_mov_b64 s[16:17], s[8:9]
    s_mov_b32 s43, s10
    s_mov_b32 s88, s11
    s_mov_b32 s44, s37
    s_mov_b32 s5, 1
    s_mov_b32 s38, 0
    s_branch L_loop
L_nxt3:
    s_cmp_lg_u32 s57, 0
    s_cbranch_scc1 L_fin
    s_waitcnt lgkmcnt(0)
    s_mov_b32 s54, s20
    s_cmp_ge_u32 s54, 24
    s_cbranch_scc1 L_last3
    s_mov_b64 s[16:17], s[6:7]
    s_mov_b32 s5, 0
    s_cmp_eq_u32 s54, 23
    s_cbranch_scc1 L_plain3
    s_cmp_gt_u32 s54, 23
    s_subb_u32 s54, s54, 0
    s_add_u32 s55, s59, 11894784
    s_add_u32 s56, s59, 12570624
    s_mov_b32 s68, 33792
    v_mov_b32 v1, v17
    s_mov_b32 s89, 3072
    s_mov_b32 s90, 36864
    s_mov_b32 s44, 2
    s_mov_b32 s47, 0x40
    s_cmp_lt_u32 s54, 16
    s_cselect_b32 s44, 4, s44
    s_cselect_b32 s47, 0x20, s47
    s_cmp_lt_u32 s54, 8
    s_cselect_b32 s44, 8, s44
    s_cselect_b32 s47, 0x0, s47
    s_mul_i32 s54, s54, s44
    s_add_u32 s54, s54, s47
    s_add_u32 s54, s54, s69
    s_sub_u32 s47, s54, 110
    s_cmp_ge_u32 s54, 110
    s_cselect_b32 s54, s47, s54
    s_mul_hi_u32 s48, s54, 390451573
    s_mul_i32 s48, s48, 11
    s_sub_u32 s54, s54, s48
    s_sub_u32 s88, 11, s54
    s_mul_i32 s48, s48, 6144
    s_mul_i32 s54, s54, 3072
    s_add_u32 s43, s55, s48
    s_add_u32 s43, s43, s54
L_set3:
    s_mov_b32 s10, s43
    s_mov_b32 s11, s88
    s_mov_b32 s37, s44
    s_lshl_b32 s42, s44, 1
    s_branch L_loop
L_plain3:
    v_mov_b32 v1, v2
    s_mov_b32 s89, 3072
    s_mov_b32 s90, 3072
    s_add_u32 s43, s59, 12570624
    s_mov_b32 s56, -1
    s_mov_b32 s68, 6144
    s_mov_b32 s44, 2
    s_branch L_set3
L_last3:
    s_mov_b32 s71, s21
    s_mov_b32 s18, 0
    s_mov_b32 s43, 0
    s_mov_b32 s68, 0
    s_mov_b32 s57, 1
    s_mov_b32 s44, 4
    s_branch L_loop
L_chk3:
    s_mov_b32 s65, 1
    s_atomic_add s65, s[12:13], s64 glc
    s_waitcnt lgkmcnt(0)
    s_cmp_lg_u32 s65, 0
    s_cbranch_scc1 L_spin3
    v_mov_b32 v44, -1
    v_mov_b32 v45, -1
    v_mov_b32 v46, -1
    v_mov_b32 v47, -1
    v_mov_b32 v8, 0
    v_lshlrev_b32 v9, 2, v0
    buffer_store_dword v8, v9, s[32:35], s49 offen sc1
    buffer_store_dwordx4 v[44:47], v4, s[32:35], s24 offen sc1
    buffer_store_dwordx4 v[44:47], v4, s[32:35], s25 offen sc1
    buffer_store_dwordx4 v[44:47], v4, s[32:35], s26 offen sc1
    buffer_store_dwordx4 v[44:47], v4, s[32:35], s27 offen sc1
    buffer_store_dwordx4 v[44:47], v4, s[32:35], s28 offen sc1
    buffer_store_dwordx4 v[44:47], v4, s[32:35], s29 offen sc1
    buffer_store_dwordx4 v[44:47], v4, s[32:35], s30 offen sc1
    buffer_store_dwordx4 v[44:47], v4, s[32:35], s31 offen sc1
    s_mov_b32 s65, 0x10000
    s_mov_b32 s67, 0x10000
    s_waitcnt vmcnt(0)
    s_atomic_add s67, s[12:13], s64 glc
    s_waitcnt lgkmcnt(0)
    s_branch L_req3
L_spin3:
    s_cmp_ge_u32 s65, 0x10000
    s_cbranch_scc1 L_req3
    s_add_u32 s58, s58, 1
    s_cmp_ge_u32 s58, 0x10000
    s_cbranch_scc1 L_giveup3
    s_sleep 2
    s_mov_b32 s65, 0
    s_atomic_add s65, s[12:13], s64 glc
    s_waitcnt lgkmcnt(0)
    s_branch L_spin3
L_giveup3:
    s_mov_b32 s65, 0x10000
    s_branch L_req3
L_event:
    s_load_dword s65, s[12:13], s64 glc
    s_branch L_seg0
L_fin:
    s_waitcnt lgkmcnt(0)
    s_add_u32 s71, s71, s42
    s_cmp_lg_u32 s71, 4096
    s_cbranch_scc1 L_nold
    buffer_load_dwordx4 v[52:55], v4, s[32:35], s25 offen sc1
    buffer_load_dwordx4 v[56:59], v4, s[32:35], s26 offen sc1
    buffer_load_dwordx4 v[60:63], v4, s[32:35], s27 offen sc1
    buffer_load_dwordx4 v[64:67], v4, s[32:35], s28 offen sc1
    buffer_load_dwordx4 v[68:71], v4, s[32:35], s29 offen sc1
    buffer_load_dwordx4 v[72:75], v4, s[32:35], s30 offen sc1
    buffer_load_dwordx4 v[76:79], v4, s[32:35], s31 offen sc1
L_nold:
    v_add_f32_dpp v7, v7, v7 row_mirror row_mask:0xf bank_mask:0xf
    s_nop 1
    v_add_f32_dpp v7, v7, v7 row_bcast:15 row_mask:0xa bank_mask:0xf
    s_nop 1
    v_add_f32_dpp v7, v7, v7 row_bcast:31 row_mask:0xc bank_mask:0xf
    s_nop 1
    v_readlane_b32 s46, v7, 63
    v_permlane32_swap_b32 v32, v36
    v_permlane32_swap_b32 v33, v37
    v_permlane32_swap_b32 v34, v38
    v_permlane32_swap_b32 v35, v39
    v_permlane32_swap_b32 v40, v42
    v_permlane32_swap_b32 v41, v43
    v_mov_b32 v46, v5
    v_mov_b32 v47, s46
    v_add_f32_dpp v44, v40, v42 row_ror:8 row_mask:0xf bank_mask:0xc
    v_add_f32_dpp v45, v41, v43 row_ror:8 row_mask:0xf bank_mask:0xc
    v_add_f32_dpp v44, v36, v32 row_ror:8 row_mask:0xf bank_mask:0x3
    v_add_f32_dpp v45, v37, v33 row_ror:8 row_mask:0xf bank_mask:0x3
    v_add_f32_dpp v46, v38, v34 row_ror:8 row_mask:0xf bank_mask:0x3
    v_add_f32_dpp v47, v39, v35 row_ror:8 row_mask:0xf bank_mask:0x3
    s_mov_b32 s58, 0
    s_cmp_eq_u32 s71, 4096
    s_cbranch_scc1 L_final
    buffer_store_dwordx4 v[44:47], v4, s[32:35], s24 offen sc1
    s_branch L_end
L_final:
    s_waitcnt vmcnt(0)
L_poll:
    v_max3_u32 v9, v52, v53, v54
    v_max3_u32 v8, v55, v56, v57
    v_max3_u32 v9, v9, v58, v59
    v_max3_u32 v8, v8, v60, v61
    v_max3_u32 v9, v9, v62, v63
    v_max3_u32 v8, v8, v64, v65
    v_max3_u32 v9, v9, v66, v67
    v_max3_u32 v8, v8, v68, v69
    v_max3_u32 v9, v9, v70, v71
    v_max3_u32 v8, v8, v72, v73
    v_max3_u32 v9, v9, v74, v75
    v_max3_u32 v8, v8, v76, v77
    v_max3_u32 v9, v9, v78, v79
    v_max_u32 v9, v9, v8
    v_cmp_eq_u32 vcc, -1, v9
    s_cbranch_vccz L_got
    s_add_u32 s58, s58, 1
    s_cmp_ge_u32 s58, 0x10000
    s_cbranch_scc1 L_got
    buffer_load_dwordx4 v[52:55], v4, s[32:35], s25 offen sc1
    buffer_load_dwordx4 v[56:59], v4, s[32:35], s26 offen sc1
    buffer_load_dwordx4 v[60:63], v4, s[32:35], s27 offen sc1
    buffer_load_dwordx4 v[64:67], v4, s[32:35], s28 offen sc1
    buffer_load_dwordx4 v[68:71], v4, s[32:35], s29 offen sc1
    buffer_load_dwordx4 v[72:75], v4, s[32:35], s30 offen sc1
    buffer_load_dwordx4 v[76:79], v4, s[32:35], s31 offen sc1
    s_waitcnt vmcnt(0)
    s_branch L_poll
L_got:
    v_max3_f32 v5, v46, v54, v58
    v_max3_f32 v6, v62, v66, v70
    v_max3_f32 v5, v5, v74, v78
    v_max_f32 v5, v5, v6
    v_mul_f32 v6, s45, v5
    v_fma_f32 v80, v46, s45, -v6
    v_fma_f32 v82, v54, s45, -v6
    v_fma_f32 v84, v58, s45, -v6
    v_fma_f32 v86, v62, s45, -v6
    v_fma_f32 v88, v66, s45, -v6
    v_fma_f32 v90, v70, s45, -v6
    v_fma_f32 v92, v74, s45, -v6
    v_fma_f32 v94, v78, s45, -v6
    v_exp_f32 v80, v80
    v_exp_f32 v82, v82
    v_exp_f32 v84, v84
    v_exp_f32 v86, v86
    v_exp_f32 v88, v88
    v_exp_f32 v90, v90
    v_exp_f32 v92, v92
    v_exp_f32 v94, v94
    v_mul_f32 v7, v80, v47
    v_mul_f32 v8, v82, v55
    v_fmac_f32 v7, v84, v59
    v_fmac_f32 v8, v86, v63
    v_fmac_f32 v7, v88, v67
    v_fmac_f32 v8, v90, v71
    v_fmac_f32 v7, v92, v75
    v_fmac_f32 v8, v94, v79
    v_add_f32 v7, v7, v8
    v_rcp_f32 v7, v7
    s_nop 0
    v_mul_f32 v80, v7, v80
    v_mul_f32 v82, v7, v82
    v_mul_f32 v84, v7, v84
    v_mul_f32 v86, v7, v86
    v_mul_f32 v88, v7, v88
    v_mul_f32 v90, v7, v90
    v_mul_f32 v92, v7, v92
    v_mul_f32 v94, v7, v94
    v_mov_b32_dpp v80, v80 row_ror:8 row_mask:0xf bank_mask:0x3
    v_mov_b32_dpp v82, v82 row_ror:8 row_mask:0xf bank_mask:0x3
    v_mov_b32_dpp v84, v84 row_ror:8 row_mask:0xf bank_mask:0x3
    v_mov_b32_dpp v86, v86 row_ror:8 row_mask:0xf bank_mask:0x3
    v_mov_b32_dpp v88, v88 row_ror:8 row_mask:0xf bank_mask:0x3
    v_mov_b32_dpp v90, v90 row_ror:8 row_mask:0xf bank_mask:0x3
    v_mov_b32_dpp v92, v92 row_ror:8 row_mask:0xf bank_mask:0x3
    v_mov_b32_dpp v94, v94 row_ror:8 row_mask:0xf bank_mask:0x3
    v_pk_mul_f32 v[32:33], v[44:45], v[80:81] op_sel_hi:[1,0]
    v_pk_mul_f32 v[34:35], v[46:47], v[80:81] op_sel_hi:[1,0]
    v_pk_fma_f32 v[32:33], v[52:53], v[82:83], v[32:33] op_sel_hi:[1,0,1]
    v_pk_fma_f32 v[34:35], v[54:55], v[82:83], v[34:35] op_sel_hi:[1,0,1]
    v_pk_fma_f32 v[32:33], v[56:57], v[84:85], v[32:33] op_sel_hi:[1,0,1]
    v_pk_fma_f32 v[34:35], v[58:59], v[84:85], v[34:35] op_sel_hi:[1,0,1]
    v_pk_fma_f32 v[32:33], v[60:61], v[86:87], v[32:33] op_sel_hi:[1,0,1]
    v_pk_fma_f32 v[34:35], v[62:63], v[86:87], v[34:35] op_sel_hi:[1,0,1]
    v_pk_fma_f32 v[32:33], v[64:65], v[88:89], v[32:33] op_sel_hi:[1,0,1]
    v_pk_fma_f32 v[34:35], v[66:67], v[88:89], v[34:35] op_sel_hi:[1,0,1]
    v_pk_fma_f32 v[32:33], v[68:69], v[90:91], v[32:33] op_sel_hi:[1,0,1]
    v_pk_fma_f32 v[34:35], v[70:71], v[90:91], v[34:35] op_sel_hi:[1,0,1]
    v_pk_fma_f32 v[32:33], v[72:73], v[92:93], v[32:33] op_sel_hi:[1,0,1]
    v_pk_fma_f32 v[34:35], v[74:75], v[92:93], v[34:35] op_sel_hi:[1,0,1]
    v_pk_fma_f32 v[32:33], v[76:77], v[94:95], v[32:33] op_sel_hi:[1,0,1]
    v_pk_fma_f32 v[34:35], v[78:79], v[94:95], v[34:35] op_sel_hi:[1,0,1]
    v_cvt_pk_bf16_f32 v32, v32, v33
    v_cvt_pk_bf16_f32 v33, v34, v35
    s_mov_b32 exec_lo, 0x00ff00ff
    s_mov_b32 exec_hi, 0x00ff00ff
    buffer_store_dwordx2 v[32:33], v18, s[96:99], s36 offen
    s_mov_b32 exec_lo, 0xff00ff00
    s_mov_b32 exec_hi, 0xff00ff00
    buffer_store_dword v32, v19, s[96:99], s36 offen offset:256
L_end:
    s_endpgm
L_rare0:
    s_mov_b32 s23, 1
    v_cmp_gt_f32 vcc, v154, v5
    v_mov_b32 v8, v154
    s_cbranch_vccz L_back0
    s_nop 1
    v_max_f32_dpp v8, v8, v8 row_mirror row_mask:0xf bank_mask:0xf
    s_nop 1
    v_max_f32_dpp v8, v8, v8 row_bcast:15 row_mask:0xa bank_mask:0xf
    s_nop 1
    v_max_f32_dpp v8, v8, v8 row_bcast:31 row_mask:0xc bank_mask:0xf
    s_nop 1
    v_readlane_b32 s46, v8, 63
    s_nop 1
    v_subrev_f32 v9, s46, v5
    v_mov_b32 v5, s46
    v_mul_f32 v9, s45, v9
    v_mul_f32 v6, s45, v5
    v_exp_f32 v9, v9
    s_nop 0
    v_mul_f32 v32, v9, v32
    v_mul_f32 v33, v9, v33
    v_mul_f32 v34, v9, v34
    v_mul_f32 v35, v9, v35
    v_mul_f32 v36, v9, v36
    v_mul_f32 v37, v9, v37
    v_mul_f32 v38, v9, v38
    v_mul_f32 v39, v9, v39
    v_mul_f32 v40, v9, v40
    v_mul_f32 v41, v9, v41
    v_mul_f32 v42, v9, v42
    v_mul_f32 v43, v9, v43
    v_mul_f32 v7, v9, v7
    s_branch L_back0
L_rare1:
    s_mov_b32 s23, 1
    v_cmp_gt_f32 vcc, v154, v5
    v_mov_b32 v8, v154
    s_cbranch_vccz L_back1
    s_nop 1
    v_max_f32_dpp v8, v8, v8 row_mirror row_mask:0xf bank_mask:0xf
    s_nop 1
    v_max_f32_dpp v8, v8, v8 row_bcast:15 row_mask:0xa bank_mask:0xf
    s_nop 1
    v_max_f32_dpp v8, v8, v8 row_bcast:31 row_mask:0xc bank_mask:0xf
    s_nop 1
    v_readlane_b32 s46, v8, 63
    s_nop 1
    v_subrev_f32 v9, s46, v5
    v_mov_b32 v5, s46
    v_mul_f32 v9, s45, v9
    v_mul_f32 v6, s45, v5
    v_exp_f32 v9, v9
    s_nop 0
    v_mul_f32 v32, v9, v32
    v_mul_f32 v33, v9, v33
    v_mul_f32 v34, v9, v34
    v_mul_f32 v35, v9, v35
    v_mul_f32 v36, v9, v36
    v_mul_f32 v37, v9, v37
    v_mul_f32 v38, v9, v38
    v_mul_f32 v39, v9, v39
    v_mul_f32 v40, v9, v40
    v_mul_f32 v41, v9, v41
    v_mul_f32 v42, v9, v42
    v_mul_f32 v43, v9, v43
    v_mul_f32 v7, v9, v7
    s_branch L_back1
L_rare2:
    s_mov_b32 s23, 1
    v_cmp_gt_f32 vcc, v154, v5
    v_mov_b32 v8, v154
    s_cbranch_vccz L_back2
    s_nop 1
    v_max_f32_dpp v8, v8, v8 row_mirror row_mask:0xf bank_mask:0xf
    s_nop 1
    v_max_f32_dpp v8, v8, v8 row_bcast:15 row_mask:0xa bank_mask:0xf
    s_nop 1
    v_max_f32_dpp v8, v8, v8 row_bcast:31 row_mask:0xc bank_mask:0xf
    s_nop 1
    v_readlane_b32 s46, v8, 63
    s_nop 1
    v_subrev_f32 v9, s46, v5
    v_mov_b32 v5, s46
    v_mul_f32 v9, s45, v9
    v_mul_f32 v6, s45, v5
    v_exp_f32 v9, v9
    s_nop 0
    v_mul_f32 v32, v9, v32
    v_mul_f32 v33, v9, v33
    v_mul_f32 v34, v9, v34
    v_mul_f32 v35, v9, v35
    v_mul_f32 v36, v9, v36
    v_mul_f32 v37, v9, v37
    v_mul_f32 v38, v9, v38
    v_mul_f32 v39, v9, v39
    v_mul_f32 v40, v9, v40
    v_mul_f32 v41, v9, v41
    v_mul_f32 v42, v9, v42
    v_mul_f32 v43, v9, v43
    v_mul_f32 v7, v9, v7
    s_branch L_back2
L_rare3:
    s_mov_b32 s23, 1
    v_cmp_gt_f32 vcc, v154, v5
    v_mov_b32 v8, v154
    s_cbranch_vccz L_back3
    s_nop 1
    v_max_f32_dpp v8, v8, v8 row_mirror row_mask:0xf bank_mask:0xf
    s_nop 1
    v_max_f32_dpp v8, v8, v8 row_bcast:15 row_mask:0xa bank_mask:0xf
    s_nop 1
    v_max_f32_dpp v8, v8, v8 row_bcast:31 row_mask:0xc bank_mask:0xf
    s_nop 1
    v_readlane_b32 s46, v8, 63
    s_nop 1
    v_subrev_f32 v9, s46, v5
    v_mov_b32 v5, s46
    v_mul_f32 v9, s45, v9
    v_mul_f32 v6, s45, v5
    v_exp_f32 v9, v9
    s_nop 0
    v_mul_f32 v32, v9, v32
    v_mul_f32 v33, v9, v33
    v_mul_f32 v34, v9, v34
    v_mul_f32 v35, v9, v35
    v_mul_f32 v36, v9, v36
    v_mul_f32 v37, v9, v37
    v_mul_f32 v38, v9, v38
    v_mul_f32 v39, v9, v39
    v_mul_f32 v40, v9, v40
    v_mul_f32 v41, v9, v41
    v_mul_f32 v42, v9, v42
    v_mul_f32 v43, v9, v43
    v_mul_f32 v7, v9, v7
    s_branch L_back3
.section .rodata,"a"
.p2align 6
.amdhsa_kernel standalone__mha_softmax__decode_kernel
  .amdhsa_next_free_vgpr 155
  .amdhsa_next_free_sgpr 102
  .amdhsa_accum_offset 156
  .amdhsa_group_segment_fixed_size 0
  .amdhsa_kernarg_size 48
  .amdhsa_user_sgpr_count 2
  .amdhsa_user_sgpr_kernarg_segment_ptr 1
  .amdhsa_system_sgpr_workgroup_id_x 1
.end_amdhsa_kernel
```
